```python
import torch

def _softmax(x, axis=-1):
    return torch.softmax(x, dim=axis)
def _gelu(x):
    return torch.nn.functional.gelu(x, approximate="tanh")
def _silu(x):
    return torch.nn.functional.silu(x)
def _sigmoid(x):
    return torch.sigmoid(x)
def _layernorm(x, axis=-1, eps=1e-5):
    m = x.mean(dim=axis, keepdim=True)
    v = x.var(dim=axis, keepdim=True, unbiased=False)
    return (x - m) / torch.sqrt(v + eps)
def _scatter_add(tgt, idx, src, axis=0):
    return tgt.clone().index_add_(axis, idx, src)
def _segment_sum(src, seg, n):
    out = torch.zeros((n,) + src.shape[1:], dtype=src.dtype)
    return out.index_add_(0, seg, src)
def _pad(x, pw):
    flat = tuple(v for pair in reversed(pw) for v in pair)
    return torch.nn.functional.pad(x, flat)

kernel_name = 'standalone__sliding_local_fixed_window__prompt'

def setup_inputs():

    _w = (lambda a: (lambda t: t.to(torch.bfloat16) if t.is_floating_point() else t)(torch.as_tensor(a)))
    B, H, S, D = 1, 32, 2048, 128
    return {
        "q": _w((lambda *s: torch.randn(*s, dtype=torch.bfloat16) * 0.8)(B, H, S, D)),
        "k": _w((lambda *s: torch.randn(*s, dtype=torch.bfloat16) * 0.8)(B, H, S, D)),
        "v": _w((lambda *s: torch.randn(*s, dtype=torch.bfloat16) * 0.05)(B, H, S, D)),
    }

def reference(q, k, v):
    B, H, S, D = q.shape
    w = 32
    pos = torch.arange(S)
    rel = pos[:, None] - pos[None, :]
    mask = (rel >= 0) & (rel < w)
    scores = torch.einsum("bhqd,bhkd->bhqk", q, k) * (D ** -0.5)
    scores = torch.where(mask[None, None], scores, (lambda x, dt: x.to(dt))(torch.as_tensor(-1e9), q.dtype))
    p = _softmax(scores, axis=-1)
    return torch.einsum("bhqk,bhkd->bhqd", p, v)
```

```asm
; @launch grid=(256,1,1) block=(384,1,1) lds=147712
.amdgcn_target "amdgcn-amd-amdhsa--gfx950"
.text
.globl standalone__sliding_local_fixed_window__prompt_kernel
.p2align 12
.fill 832, 4, 0xbf810000
.p2align 8
.type standalone__sliding_local_fixed_window__prompt_kernel,@function
standalone__sliding_local_fixed_window__prompt_kernel:
    s_load_dwordx2 s[16:17], s[0:1], 8
    s_load_dwordx2 s[20:21], s[0:1], 16
    s_load_dwordx2 s[12:13], s[0:1], 0
    s_load_dwordx2 s[24:25], s[0:1], 24
    s_cmp_ge_u32 s2, 256
    s_cbranch_scc1 L_end
    v_lshrrev_b32 v5, 6, v0
    v_and_b32 v0, 63, v0
    v_readfirstlane_b32 s3, v5
    v_mov_b32 v1, 147468
    v_lshl_add_u32 v15, v5, 2, v1
    v_add_u32 v5, 1, v5
    ds_write_b32 v15, v5
    s_bfe_u32 s60, s2, 0x40003
    s_and_b32 s61, s2, 1
    s_lshl4_add_u32 s60, s61, s60
    s_lshr_b32 s61, s2, 7
    s_and_b32 s2, s2, 6
    s_or_b32 s2, s2, s61
    s_lshl_b32 s2, s2, 5
    s_or_b32 s2, s2, s60
    s_lshl_b32 s39, s2, 16
    s_movk_i32 s37, 4096
    s_movk_i32 s61, -8192
    s_and_b32 s60, s2, 1
    s_cmovk_i32 s37, -4096
    s_cselect_b32 s60, 61440, 0
    s_cselect_b32 s61, s60, s61
    s_cselect_b64 s[42:43], -1, 0
    s_add_u32 s38, s39, s61
    s_add_u32 s39, s39, s60
    v_lshrrev_b32 v6, 4, v0
    v_and_b32 v7, 15, v0
    s_mov_b32 s14, 16777216
    s_mov_b32 s15, 0x20000
    s_mov_b64 s[26:27], s[14:15]
    v_lshlrev_b32 v5, 1, v6
    v_xor_b32 v5, v5, v7
    v_lshlrev_b32 v5, 4, v5
    v_lshl_add_u32 v2, v6, 8, v5
    v_xor_b32 v3, 128, v2
    s_add_u32 s45, s38, s37
    s_and_b32 s40, s2, 7
    s_cselect_b32 s44, s38, 0
    s_cselect_b32 s45, s45, 0
    s_cselect_b32 s18, s14, 0
    s_mov_b32 s19, 0x20000
    s_mov_b64 s[22:23], s[18:19]
    s_mov_b32 m0, 65536
    s_cmp_lg_u32 s3, 0
    s_waitcnt lgkmcnt(0)
    s_cbranch_scc1 L_other
    buffer_load_dwordx4 v2, s[16:19], s44 offen offset:0 nt lds
    buffer_load_dwordx4 v3, s[16:19], s44 offen offset:1024 nt lds
    buffer_load_dwordx4 v2, s[16:19], s44 offen offset:2048 nt lds
    buffer_load_dwordx4 v3, s[16:19], s44 offen offset:3072 nt lds
    s_addk_i32 m0, 4096
    s_setprio 3
    buffer_load_dwordx4 v2, s[20:23], s44 offen offset:0 nt lds
    buffer_load_dwordx4 v3, s[20:23], s44 offen offset:1024 nt lds
    buffer_load_dwordx4 v2, s[20:23], s44 offen offset:2048 nt lds
    buffer_load_dwordx4 v3, s[20:23], s44 offen offset:3072 nt lds
    s_addk_i32 m0, 4096
    s_mov_b32 s46, s39
    buffer_load_dwordx4 v2, s[16:19], s45 offen offset:0 nt lds
    buffer_load_dwordx4 v3, s[16:19], s45 offen offset:1024 nt lds
    buffer_load_dwordx4 v2, s[16:19], s45 offen offset:2048 nt lds
    buffer_load_dwordx4 v3, s[16:19], s45 offen offset:3072 nt lds
    s_addk_i32 m0, 4096
    s_mov_b32 s47, 0
    buffer_load_dwordx4 v2, s[20:23], s45 offen offset:0 nt lds
    buffer_load_dwordx4 v3, s[20:23], s45 offen offset:1024 nt lds
    buffer_load_dwordx4 v2, s[20:23], s45 offen offset:2048 nt lds
    buffer_load_dwordx4 v3, s[20:23], s45 offen offset:3072 nt lds
    s_lshl1_add_u32 s48, s37, s38
    s_mov_b32 s50, s48
    s_mov_b32 s49, 81920
    s_add_u32 s51, s49, 4096
    s_mov_b32 s52, 4
    s_movk_i32 s53, 4096
    s_getreg_b32 s54, hwreg(HW_REG_XCC_ID, 0, 1)
    s_cmp_eq_u32 s54, 0
    s_cselect_b32 s54, 48, 0
    v_mov_b32 v4, -6
    s_barrier
L_ld:
    s_mov_b32 m0, s47
    s_lshl1_add_u32 s58, s53, s47
    s_lshl1_add_u32 s59, s37, s46
    s_waitcnt vmcnt(32)
    s_cmp_ge_u32 s52, s54
    s_cbranch_scc1 L_nw0
    s_waitcnt vmcnt(25)
L_nw0:
    v_add_u32 v4, 2, v4
    ds_write_b32 v1, v4
    buffer_load_dwordx4 v2, s[12:15], s46 offen offset:0 nt lds
    buffer_load_dwordx4 v3, s[12:15], s46 offen offset:1024 nt lds
    s_mov_b32 m0, s58
    ds_read_b128 v[8:11], v1 offset:4
    buffer_load_dwordx4 v2, s[12:15], s59 offen offset:0 nt lds
    buffer_load_dwordx4 v3, s[12:15], s59 offen offset:1024 nt lds
    s_mov_b32 m0, s47
    s_waitcnt vmcnt(32)
    s_cmp_ge_u32 s52, s54
    s_cbranch_scc1 L_nw1
    s_waitcnt vmcnt(25)
L_nw1:
    buffer_load_dwordx4 v2, s[12:15], s46 offen offset:2048 nt lds
    buffer_load_dwordx4 v3, s[12:15], s46 offen offset:3072 nt lds
    s_mov_b32 m0, s58
    s_add_u32 s52, s52, 2
    buffer_load_dwordx4 v2, s[12:15], s59 offen offset:2048 nt lds
    buffer_load_dwordx4 v3, s[12:15], s59 offen offset:3072 nt lds
    s_add_u32 s46, s46, s37
    s_add_u32 s47, s47, s53
    s_and_b32 s60, s52, 3
    s_cbranch_scc1 L_ld
    s_lshl1_add_u32 s46, s37, s46
    s_lshl1_add_u32 s47, s53, s47
    s_cmp_ge_u32 s47, 147456
    s_cselect_b32 s60, 81920, 0
    s_sub_u32 s47, s47, s60
    s_mov_b64 s[60:61], s[12:13]
    s_mov_b64 s[12:13], s[16:17]
    s_mov_b64 s[16:17], s[20:21]
    s_mov_b64 s[20:21], s[60:61]
    s_mov_b64 s[60:61], s[46:47]
    s_mov_b64 s[46:47], s[48:49]
    s_mov_b64 s[48:49], s[50:51]
    s_mov_b64 s[50:51], s[60:61]
    s_movk_i32 s53, 4096
    s_cmp_ge_u32 s47, 65536
    s_cmovk_i32 s53, 8192
    s_cmp_ge_u32 s52, 44
    s_cselect_b32 s55, 9, 5
    s_cmp_lt_u32 s52, 32
    s_cmov_b32 s55, 0
    s_cmp_eq_u32 s52, 52
    s_cbranch_scc1 L_drain
L_free:
    s_waitcnt lgkmcnt(0)
    v_min3_i32 v8, v8, v9, v10
    v_min_i32 v8, v8, v11
    v_cmp_lt_i32 vcc, s55, v8
    s_cbranch_vccnz L_ld
    ds_read_b128 v[8:11], v1 offset:4
    s_branch L_free
L_drain:
    v_mov_b32 v4, 46
    s_waitcnt vmcnt(24)
    ds_write_b32 v1, v4
    v_mov_b32 v4, 48
    s_waitcnt vmcnt(16)
    ds_write_b32 v1, v4
    v_mov_b32 v4, 50
    s_waitcnt vmcnt(8)
    ds_write_b32 v1, v4
    v_mov_b32 v4, 52
    s_waitcnt vmcnt(0)
    ds_write_b32 v1, v4
    s_endpgm
L_other:
    s_barrier
    v_xor_b32 v5, v7, v6
    v_lshlrev_b32 v5, 4, v5
    v_lshl_add_u32 v3, v6, 8, v5
    v_xor_b32 v4, 64, v3
    s_cmp_le_u32 s3, 4
    s_cbranch_scc1 L_consumer
    v_lshlrev_b32 v2, 4, v0
L_sr0:
    ds_read_b128 v[8:11], v1 offset:4
    s_waitcnt lgkmcnt(0)
    v_min3_i32 v8, v8, v9, v10
    v_min_i32 v8, v8, v11
    v_cmp_ge_i32 vcc, 5, v8
    s_cbranch_vccnz L_sr0
    ds_read_b128 v[16:19], v2 offset:0
    ds_read_b128 v[20:23], v2 offset:1024
    ds_read_b128 v[24:27], v2 offset:2048
    ds_read_b128 v[28:31], v2 offset:3072
    ds_read_b128 v[32:35], v2 offset:4096
    ds_read_b128 v[36:39], v2 offset:5120
    ds_read_b128 v[40:43], v2 offset:6144
    ds_read_b128 v[44:47], v2 offset:7168
    ds_read_b128 v[48:51], v2 offset:8192
    ds_read_b128 v[52:55], v2 offset:9216
    ds_read_b128 v[56:59], v2 offset:10240
    ds_read_b128 v[60:63], v2 offset:11264
    ds_read_b128 v[64:67], v2 offset:12288
    ds_read_b128 v[68:71], v2 offset:13312
    s_waitcnt lgkmcnt(6)
    ds_read_b128 v[72:75], v2 offset:14336
    ds_read_b128 v[76:79], v2 offset:15360
L_sr1:
    ds_read_b128 v[8:11], v1 offset:4
    s_waitcnt lgkmcnt(0)
    v_min3_i32 v8, v8, v9, v10
    v_min_i32 v8, v8, v11
    v_cmp_ge_i32 vcc, 9, v8
    s_cbranch_vccnz L_sr1
    ds_read_b128 v[80:83], v2 offset:16384
    ds_read_b128 v[84:87], v2 offset:17408
    ds_read_b128 v[88:91], v2 offset:18432
    ds_read_b128 v[92:95], v2 offset:19456
    ds_read_b128 v[96:99], v2 offset:20480
    ds_read_b128 v[100:103], v2 offset:21504
    ds_read_b128 v[104:107], v2 offset:22528
    ds_read_b128 v[108:111], v2 offset:23552
    ds_read_b128 v[112:115], v2 offset:24576
    ds_read_b128 v[116:119], v2 offset:25600
    ds_read_b128 v[120:123], v2 offset:26624
    ds_read_b128 v[124:127], v2 offset:27648
    ds_read_b128 v[128:131], v2 offset:28672
    ds_read_b128 v[132:135], v2 offset:29696
    s_waitcnt lgkmcnt(6)
    ds_read_b128 v[136:139], v2 offset:30720
    ds_read_b128 v[140:143], v2 offset:31744
L_strig:
    ds_read_b32 v8, v1
    s_waitcnt lgkmcnt(0)
    v_cmp_gt_i32 vcc, 48, v8
    s_cbranch_vccnz L_strig
    buffer_store_dwordx4 v[16:19], v3, s[24:27], s39 offen offset:0 sc1 nt
    buffer_store_dwordx4 v[20:23], v4, s[24:27], s39 offen offset:1024 sc1 nt
    buffer_store_dwordx4 v[24:27], v3, s[24:27], s39 offen offset:2048 sc1 nt
    buffer_store_dwordx4 v[28:31], v4, s[24:27], s39 offen offset:3072 sc1 nt
    s_add_u32 s39, s39, s37
    buffer_store_dwordx4 v[32:35], v3, s[24:27], s39 offen offset:0 sc1 nt
    buffer_store_dwordx4 v[36:39], v4, s[24:27], s39 offen offset:1024 sc1 nt
    buffer_store_dwordx4 v[40:43], v3, s[24:27], s39 offen offset:2048 sc1 nt
    buffer_store_dwordx4 v[44:47], v4, s[24:27], s39 offen offset:3072 sc1 nt
    s_add_u32 s39, s39, s37
    buffer_store_dwordx4 v[48:51], v3, s[24:27], s39 offen offset:0 sc1 nt
    buffer_store_dwordx4 v[52:55], v4, s[24:27], s39 offen offset:1024 sc1 nt
    buffer_store_dwordx4 v[56:59], v3, s[24:27], s39 offen offset:2048 sc1 nt
    buffer_store_dwordx4 v[60:63], v4, s[24:27], s39 offen offset:3072 sc1 nt
    s_add_u32 s39, s39, s37
    buffer_store_dwordx4 v[64:67], v3, s[24:27], s39 offen offset:0 sc1 nt
    buffer_store_dwordx4 v[68:71], v4, s[24:27], s39 offen offset:1024 sc1 nt
    buffer_store_dwordx4 v[72:75], v3, s[24:27], s39 offen offset:2048 sc1 nt
    buffer_store_dwordx4 v[76:79], v4, s[24:27], s39 offen offset:3072 sc1 nt
    s_add_u32 s39, s39, s37
    buffer_store_dwordx4 v[80:83], v3, s[24:27], s39 offen offset:0 sc1 nt
    buffer_store_dwordx4 v[84:87], v4, s[24:27], s39 offen offset:1024 sc1 nt
    buffer_store_dwordx4 v[88:91], v3, s[24:27], s39 offen offset:2048 sc1 nt
    buffer_store_dwordx4 v[92:95], v4, s[24:27], s39 offen offset:3072 sc1 nt
    s_add_u32 s39, s39, s37
    buffer_store_dwordx4 v[96:99], v3, s[24:27], s39 offen offset:0 sc1 nt
    buffer_store_dwordx4 v[100:103], v4, s[24:27], s39 offen offset:1024 sc1 nt
    buffer_store_dwordx4 v[104:107], v3, s[24:27], s39 offen offset:2048 sc1 nt
    buffer_store_dwordx4 v[108:111], v4, s[24:27], s39 offen offset:3072 sc1 nt
    s_add_u32 s39, s39, s37
    buffer_store_dwordx4 v[112:115], v3, s[24:27], s39 offen offset:0 sc1 nt
    buffer_store_dwordx4 v[116:119], v4, s[24:27], s39 offen offset:1024 sc1 nt
    buffer_store_dwordx4 v[120:123], v3, s[24:27], s39 offen offset:2048 sc1 nt
    buffer_store_dwordx4 v[124:127], v4, s[24:27], s39 offen offset:3072 sc1 nt
    s_add_u32 s39, s39, s37
    buffer_store_dwordx4 v[128:131], v3, s[24:27], s39 offen offset:0 sc1 nt
    buffer_store_dwordx4 v[132:135], v4, s[24:27], s39 offen offset:1024 sc1 nt
    buffer_store_dwordx4 v[136:139], v3, s[24:27], s39 offen offset:2048 sc1 nt
    buffer_store_dwordx4 v[140:143], v4, s[24:27], s39 offen offset:3072 sc1 nt
    s_add_u32 s39, s39, s37
L_sr2:
    ds_read_b128 v[8:11], v1 offset:4
    s_waitcnt lgkmcnt(0)
    v_min3_i32 v8, v8, v9, v10
    v_min_i32 v8, v8, v11
    v_cmp_ge_i32 vcc, 13, v8
    s_cbranch_vccnz L_sr2
    ds_read_b128 v[144:147], v2 offset:32768
    ds_read_b128 v[148:151], v2 offset:33792
    ds_read_b128 v[152:155], v2 offset:34816
    ds_read_b128 v[156:159], v2 offset:35840
    ds_read_b128 v[160:163], v2 offset:36864
    ds_read_b128 v[164:167], v2 offset:37888
    ds_read_b128 v[168:171], v2 offset:38912
    ds_read_b128 v[172:175], v2 offset:39936
    ds_read_b128 v[176:179], v2 offset:40960
    ds_read_b128 v[180:183], v2 offset:41984
    ds_read_b128 v[184:187], v2 offset:43008
    ds_read_b128 v[188:191], v2 offset:44032
    ds_read_b128 v[192:195], v2 offset:45056
    ds_read_b128 v[196:199], v2 offset:46080
    s_waitcnt lgkmcnt(6)
    ds_read_b128 v[200:203], v2 offset:47104
    ds_read_b128 v[204:207], v2 offset:48128
    buffer_store_dwordx4 v[144:147], v3, s[24:27], s39 offen offset:0 sc1 nt
    buffer_store_dwordx4 v[148:151], v4, s[24:27], s39 offen offset:1024 sc1 nt
    buffer_store_dwordx4 v[152:155], v3, s[24:27], s39 offen offset:2048 sc1 nt
    buffer_store_dwordx4 v[156:159], v4, s[24:27], s39 offen offset:3072 sc1 nt
    s_add_u32 s39, s39, s37
    buffer_store_dwordx4 v[160:163], v3, s[24:27], s39 offen offset:0 sc1 nt
    buffer_store_dwordx4 v[164:167], v4, s[24:27], s39 offen offset:1024 sc1 nt
    buffer_store_dwordx4 v[168:171], v3, s[24:27], s39 offen offset:2048 sc1 nt
    buffer_store_dwordx4 v[172:175], v4, s[24:27], s39 offen offset:3072 sc1 nt
    s_add_u32 s39, s39, s37
    s_waitcnt lgkmcnt(4)
    buffer_store_dwordx4 v[176:179], v3, s[24:27], s39 offen offset:0 sc1 nt
    buffer_store_dwordx4 v[180:183], v4, s[24:27], s39 offen offset:1024 sc1 nt
    buffer_store_dwordx4 v[184:187], v3, s[24:27], s39 offen offset:2048 sc1 nt
    buffer_store_dwordx4 v[188:191], v4, s[24:27], s39 offen offset:3072 sc1 nt
    s_add_u32 s39, s39, s37
    s_waitcnt lgkmcnt(0)
    buffer_store_dwordx4 v[192:195], v3, s[24:27], s39 offen offset:0 sc1 nt
    buffer_store_dwordx4 v[196:199], v4, s[24:27], s39 offen offset:1024 sc1 nt
    buffer_store_dwordx4 v[200:203], v3, s[24:27], s39 offen offset:2048 sc1 nt
    buffer_store_dwordx4 v[204:207], v4, s[24:27], s39 offen offset:3072 sc1 nt
    s_endpgm
L_consumer:
    v_and_b32 v13, 7, v7
    v_lshlrev_b32 v5, 1, v13
    v_xor_b32 v5, v5, v6
    v_lshlrev_b32 v5, 4, v5
    v_lshl_add_u32 v16, v7, 8, v5
    v_xor_b32 v17, 64, v16
    v_xor_b32 v18, 128, v16
    v_xor_b32 v19, 64, v18
    v_lshrrev_b32 v14, 2, v0
    v_and_b32 v5, 7, v14
    v_lshlrev_b32 v5, 5, v5
    v_lshl_add_u32 v5, v14, 8, v5
    v_and_b32 v14, 3, v0
    v_lshl_add_u32 v20, v14, 3, v5
    v_xor_b32 v24, 128, v20
    v_xor_b32 v22, 64, v20
    v_xor_b32 v26, 64, v24
    v_xor_b32 v21, 32, v20
    v_xor_b32 v23, 32, v22
    v_xor_b32 v25, 32, v24
    v_xor_b32 v27, 32, v26
    v_lshrrev_b32 v5, 1, v6
    v_xor_b32 v5, v5, v13
    v_lshlrev_b32 v5, 4, v5
    v_lshl_add_u32 v5, v7, 8, v5
    v_and_b32 v14, 1, v6
    v_lshl_add_u32 v28, v14, 3, v5
    v_xor_b32 v30, 64, v28
    v_xor_b32 v29, 32, v28
    v_xor_b32 v31, 32, v30
    v_lshlrev_b32 v13, 2, v6
    v_sub_u32 v13, v7, v13
    v_cmp_le_i32 vcc, 0, v13
    s_nop 0
    s_xor_b64 s[28:29], vcc, s[42:43]
    v_cmp_le_i32 vcc, 1, v13
    s_nop 0
    s_xor_b64 s[30:31], vcc, s[42:43]
    v_cmp_le_i32 vcc, 2, v13
    s_nop 0
    s_xor_b64 s[32:33], vcc, s[42:43]
    v_cmp_le_i32 vcc, 3, v13
    s_nop 0
    s_xor_b64 s[34:35], vcc, s[42:43]
    v_mov_b32 v13, 0xffff
    v_cndmask_b32 v10, 0, v13, s[28:29]
    v_cndmask_b32 v14, 0, v13, s[30:31]
    v_lshl_or_b32 v5, v14, 16, v10
    v_cndmask_b32 v10, 0, v13, s[32:33]
    v_cndmask_b32 v14, 0, v13, s[34:35]
    v_lshl_or_b32 v6, v14, 16, v10
    s_mov_b32 s51, 0x3fb8aa3b
    s_mov_b32 s54, 0x3db504f3
    s_mov_b32 s55, 0xffff0000
    s_cmp_eq_u32 s40, 0
    s_cselect_b32 s52, 0xf149f2ca, 0
    s_sub_u32 s60, s3, 1
    s_add_u32 s44, s60, 2
    s_cmp_eq_u32 s60, 0
    s_cselect_b32 s53, 10, 12
    s_lshl_b32 s48, s60, 12
    s_lshl_b32 s61, s60, 13
    s_add_u32 s45, s61, 65536
    v_lshl_add_u32 v2, v0, 4, s48
    s_add_u32 s60, s60, 12
    s_mul_i32 s61, s60, s37
    s_add_u32 s39, s39, s61
L_round:
    s_add_u32 s46, s45, 8192
    s_cmp_eq_u32 s46, 147456
    s_cmov_b32 s46, 65536
    s_add_u32 s47, s46, 8192
    s_cmp_eq_u32 s47, 147456
    s_cmov_b32 s47, 65536
    v_add_u32 v32, s48, v16
    v_add_u32 v36, s45, v16
    v_add_u32 v40, s46, v16
    v_add_u32 v44, s47, v16
    v_add_u32 v33, s48, v17
    v_add_u32 v37, s45, v17
    v_add_u32 v41, s46, v17
    v_add_u32 v45, s47, v17
    v_add_u32 v34, s48, v18
    v_add_u32 v38, s45, v18
    v_add_u32 v42, s46, v18
    v_add_u32 v46, s47, v18
    v_add_u32 v35, s48, v19
    v_add_u32 v39, s45, v19
    v_add_u32 v43, s46, v19
    v_add_u32 v47, s47, v19
    v_add_u32 v48, s45, v20
    v_add_u32 v56, s46, v20
    v_add_u32 v64, s47, v20
    v_add_u32 v49, s45, v21
    v_add_u32 v57, s46, v21
    v_add_u32 v65, s47, v21
    v_add_u32 v50, s45, v22
    v_add_u32 v58, s46, v22
    v_add_u32 v66, s47, v22
    v_add_u32 v51, s45, v23
    v_add_u32 v59, s46, v23
    v_add_u32 v67, s47, v23
    v_add_u32 v52, s45, v24
    v_add_u32 v60, s46, v24
    v_add_u32 v68, s47, v24
    v_add_u32 v53, s45, v25
    v_add_u32 v61, s46, v25
    v_add_u32 v69, s47, v25
    v_add_u32 v54, s45, v26
    v_add_u32 v62, s46, v26
    v_add_u32 v70, s47, v26
    v_add_u32 v55, s45, v27
    v_add_u32 v63, s46, v27
    v_add_u32 v71, s47, v27
    v_add_u32 v72, s48, v28
    v_add_u32 v73, s48, v29
    v_add_u32 v74, s48, v30
    v_add_u32 v75, s48, v31
    s_cmp_lt_u32 s44, 4
    s_cselect_b32 s60, s52, 0
    s_cmp_lt_u32 s44, 3
    s_cselect_b32 s61, s52, 0
    v_mov_b32 v188, s60
    v_mov_b32 v192, s61
    v_mov_b32 v189, s60
    v_mov_b32 v193, s61
    v_mov_b32 v190, s60
    v_mov_b32 v194, s61
    v_mov_b32 v191, s60
    v_mov_b32 v195, s61
    s_add_u32 s60, s44, 4
    v_mov_b32 v13, s60
L_poll:
    ds_read_b32 v10, v1
    s_waitcnt lgkmcnt(0)
    v_cmp_gt_i32 vcc, s53, v10
    s_cbranch_vccnz L_poll
    ds_read_b128 v[76:79], v32
    ds_read_b128 v[92:95], v36
    ds_read_b128 v[124:127], v44
    ds_read_b128 v[108:111], v40
    ds_read_b128 v[80:83], v33
    ds_read_b128 v[96:99], v37
    ds_read_b128 v[128:131], v45
    ds_read_b128 v[112:115], v41
    ds_read_b128 v[84:87], v34
    ds_read_b128 v[100:103], v38
    ds_read_b128 v[132:135], v46
    ds_read_b128 v[116:119], v42
    s_waitcnt lgkmcnt(10)
    v_mfma_f32_16x16x32_bf16 v[188:191], v[92:95], v[76:79], v[188:191]
    ds_read_b128 v[88:91], v35
    ds_read_b128 v[104:107], v39
    s_waitcnt lgkmcnt(11)
    v_mfma_f32_16x16x32_bf16 v[196:199], v[124:127], v[76:79], 0
    ds_read_b128 v[136:139], v47
    s_waitcnt lgkmcnt(11)
    v_mfma_f32_16x16x32_bf16 v[192:195], v[108:111], v[76:79], v[192:195]
    ds_read_b128 v[120:123], v43
    s_waitcnt lgkmcnt(10)
    v_mfma_f32_16x16x32_bf16 v[188:191], v[96:99], v[80:83], v[188:191]
    s_waitcnt lgkmcnt(9)
    v_mfma_f32_16x16x32_bf16 v[196:199], v[128:131], v[80:83], v[196:199]
    s_waitcnt lgkmcnt(8)
    v_mfma_f32_16x16x32_bf16 v[192:195], v[112:115], v[80:83], v[192:195]
    s_waitcnt lgkmcnt(6)
    v_mfma_f32_16x16x32_bf16 v[188:191], v[100:103], v[84:87], v[188:191]
    s_waitcnt lgkmcnt(5)
    v_mfma_f32_16x16x32_bf16 v[196:199], v[132:135], v[84:87], v[196:199]
    s_waitcnt lgkmcnt(4)
    v_mfma_f32_16x16x32_bf16 v[192:195], v[116:119], v[84:87], v[192:195]
    s_waitcnt lgkmcnt(2)
    v_mfma_f32_16x16x32_bf16 v[188:191], v[104:107], v[88:91], v[188:191]
    s_waitcnt lgkmcnt(1)
    v_mfma_f32_16x16x32_bf16 v[196:199], v[136:139], v[88:91], v[196:199]
    s_waitcnt lgkmcnt(0)
    v_mfma_f32_16x16x32_bf16 v[192:195], v[120:123], v[88:91], v[192:195]
    s_add_u32 s53, s53, 4
    ds_read_b32 v8, v1
    s_nop 3
    v_cndmask_b32 v188, v188, v196, s[28:29]
    v_cndmask_b32 v189, v189, v197, s[30:31]
    v_cndmask_b32 v190, v190, v198, s[32:33]
    v_cndmask_b32 v191, v191, v199, s[34:35]
    v_cvt_pk_bf16_f32 v189, v188, v189
    v_cvt_pk_bf16_f32 v191, v190, v191
    v_cvt_pk_bf16_f32 v193, v192, v193
    v_cvt_pk_bf16_f32 v195, v194, v195
    v_lshlrev_b32 v188, 16, v189
    v_and_b32 v189, s55, v189
    v_lshlrev_b32 v190, 16, v191
    v_and_b32 v191, s55, v191
    v_lshlrev_b32 v192, 16, v193
    v_and_b32 v193, s55, v193
    v_lshlrev_b32 v194, 16, v195
    v_and_b32 v195, s55, v195
    v_mul_f32 v188, s54, v188
    v_mul_f32 v189, s54, v189
    v_mul_f32 v190, s54, v190
    v_mul_f32 v191, s54, v191
    v_mul_f32 v192, s54, v192
    v_mul_f32 v193, s54, v193
    v_mul_f32 v194, s54, v194
    v_mul_f32 v195, s54, v195
    v_cvt_pk_bf16_f32 v189, v188, v189
    v_cvt_pk_bf16_f32 v191, v190, v191
    v_cvt_pk_bf16_f32 v193, v192, v193
    v_cvt_pk_bf16_f32 v195, v194, v195
    v_lshlrev_b32 v188, 16, v189
    v_and_b32 v189, s55, v189
    v_lshlrev_b32 v190, 16, v191
    v_and_b32 v191, s55, v191
    v_lshlrev_b32 v192, 16, v193
    v_and_b32 v193, s55, v193
    v_lshlrev_b32 v194, 16, v195
    v_and_b32 v195, s55, v195
    v_max3_f32 v12, v188, v189, v190
    v_max3_f32 v14, v191, v192, v193
    v_max3_f32 v12, v12, v194, v195
    v_max_f32 v10, v12, v14
    v_max_f32 v11, v12, v14
    s_nop 1
    v_permlane32_swap_b32 v10, v11
    v_max_f32 v12, v10, v11
    v_max_f32 v14, v10, v11
    s_nop 1
    v_permlane16_swap_b32 v12, v14
    v_max_f32 v10, v12, v14
    v_mul_f32 v10, s51, v10
    v_fma_f32 v188, v188, s51, -v10
    v_fma_f32 v189, v189, s51, -v10
    v_fma_f32 v190, v190, s51, -v10
    v_fma_f32 v191, v191, s51, -v10
    v_fma_f32 v192, v192, s51, -v10
    v_fma_f32 v193, v193, s51, -v10
    v_fma_f32 v194, v194, s51, -v10
    v_fma_f32 v195, v195, s51, -v10
    v_exp_f32 v188, v188
    v_exp_f32 v189, v189
    v_exp_f32 v190, v190
    v_exp_f32 v191, v191
    v_add_f32 v12, v188, v189
    v_exp_f32 v192, v192
    v_add_f32 v14, v190, v191
    v_exp_f32 v193, v193
    v_exp_f32 v194, v194
    v_add_f32 v12, v12, v192
    v_add_f32 v14, v14, v193
    v_exp_f32 v195, v195
L_poll2:
    s_waitcnt lgkmcnt(0)
    v_cmp_le_i32 vcc, s53, v8
    s_cbranch_vccnz L_poll2_x
    ds_read_b32 v8, v1
    s_branch L_poll2
L_poll2_x:
    ds_read_b64_tr_b16 v[144:145], v64 offset:4096
    ds_read_b64_tr_b16 v[150:151], v65 offset:4096
    ds_read_b64_tr_b16 v[156:157], v66 offset:4096
    ds_read_b64_tr_b16 v[162:163], v67 offset:4096
    ds_read_b64_tr_b16 v[140:141], v48 offset:4096
    ds_read_b64_tr_b16 v[142:143], v56 offset:4096
    ds_read_b64_tr_b16 v[146:147], v49 offset:4096
    ds_read_b64_tr_b16 v[148:149], v57 offset:4096
    v_add_f32 v12, v12, v194
    v_add_f32 v14, v14, v195
    v_add_f32 v10, v12, v14
    v_add_f32 v11, v12, v14
    ds_read_b64_tr_b16 v[152:153], v50 offset:4096
    ds_read_b64_tr_b16 v[154:155], v58 offset:4096
    v_permlane32_swap_b32 v10, v11
    v_add_f32 v12, v10, v11
    v_add_f32 v14, v10, v11
    ds_read_b64_tr_b16 v[158:159], v51 offset:4096
    ds_read_b64_tr_b16 v[160:161], v59 offset:4096
    v_permlane16_swap_b32 v12, v14
    v_add_f32 v10, v12, v14
    v_rcp_f32 v10, v10
    s_waitcnt lgkmcnt(8)
    ds_read_b64_tr_b16 v[168:169], v68 offset:4096
    ds_read_b64_tr_b16 v[174:175], v69 offset:4096
    v_mul_f32 v188, v188, v10
    v_mul_f32 v189, v189, v10
    v_mul_f32 v190, v190, v10
    v_mul_f32 v191, v191, v10
    ds_read_b64_tr_b16 v[180:181], v70 offset:4096
    ds_read_b64_tr_b16 v[186:187], v71 offset:4096
    v_cvt_pk_bf16_f32 v200, v188, v189
    v_cvt_pk_bf16_f32 v201, v190, v191
    v_and_b32 v204, v200, v5
    v_and_b32 v205, v201, v6
    v_mul_f32 v192, v192, v10
    v_mul_f32 v193, v193, v10
    v_mfma_f32_16x16x16_bf16 v[208:211], v[144:145], v[204:205], 0
    s_waitcnt lgkmcnt(6)
    ds_read_b64_tr_b16 v[164:165], v52 offset:4096
    ds_read_b64_tr_b16 v[166:167], v60 offset:4096
    v_mul_f32 v194, v194, v10
    v_mul_f32 v195, v195, v10
    v_mfma_f32_16x16x16_bf16 v[212:215], v[150:151], v[204:205], 0
    ds_read_b64_tr_b16 v[170:171], v53 offset:4096
    ds_read_b64_tr_b16 v[172:173], v61 offset:4096
    v_cvt_pk_bf16_f32 v202, v192, v193
    v_cvt_pk_bf16_f32 v203, v194, v195
    v_mfma_f32_16x16x16_bf16 v[216:219], v[156:157], v[204:205], 0
    ds_read_b64_tr_b16 v[176:177], v54 offset:4096
    ds_read_b64_tr_b16 v[178:179], v62 offset:4096
    v_xor_b32 v200, v200, v204
    v_xor_b32 v201, v201, v205
    v_mfma_f32_16x16x16_bf16 v[220:223], v[162:163], v[204:205], 0
    ds_read_b64_tr_b16 v[182:183], v55 offset:4096
    ds_read_b64_tr_b16 v[184:185], v63 offset:4096
    s_waitcnt lgkmcnt(8)
    v_mfma_f32_16x16x32_bf16 v[208:211], v[140:143], v[200:203], v[208:211]
    v_mfma_f32_16x16x16_bf16 v[224:227], v[168:169], v[204:205], 0
    v_mfma_f32_16x16x32_bf16 v[212:215], v[146:149], v[200:203], v[212:215]
    v_mfma_f32_16x16x16_bf16 v[228:231], v[174:175], v[204:205], 0
    v_mfma_f32_16x16x32_bf16 v[216:219], v[152:155], v[200:203], v[216:219]
    v_mfma_f32_16x16x16_bf16 v[232:235], v[180:181], v[204:205], 0
    v_mfma_f32_16x16x32_bf16 v[220:223], v[158:161], v[200:203], v[220:223]
    v_mfma_f32_16x16x16_bf16 v[236:239], v[186:187], v[204:205], 0
    s_waitcnt lgkmcnt(0)
    s_addk_i32 s48, 16384
    v_cvt_pk_bf16_f32 v76, v208, v209
    v_cvt_pk_bf16_f32 v77, v210, v211
    v_mfma_f32_16x16x32_bf16 v[224:227], v[164:167], v[200:203], v[224:227]
    ds_write_b64 v72, v[76:77] offset:0
    v_cvt_pk_bf16_f32 v78, v212, v213
    v_cvt_pk_bf16_f32 v79, v214, v215
    v_mfma_f32_16x16x32_bf16 v[228:231], v[170:173], v[200:203], v[228:231]
    ds_write_b64 v73, v[78:79] offset:0
    v_cvt_pk_bf16_f32 v80, v216, v217
    v_cvt_pk_bf16_f32 v81, v218, v219
    v_mfma_f32_16x16x32_bf16 v[232:235], v[176:179], v[200:203], v[232:235]
    ds_write_b64 v74, v[80:81] offset:0
    v_cvt_pk_bf16_f32 v82, v220, v221
    v_cvt_pk_bf16_f32 v83, v222, v223
    v_mfma_f32_16x16x32_bf16 v[236:239], v[182:185], v[200:203], v[236:239]
    ds_write_b64 v75, v[82:83] offset:0
    v_cvt_pk_bf16_f32 v84, v224, v225
    v_cvt_pk_bf16_f32 v85, v226, v227
    ds_write_b64 v72, v[84:85] offset:128
    v_cvt_pk_bf16_f32 v86, v228, v229
    v_cvt_pk_bf16_f32 v87, v230, v231
    ds_write_b64 v73, v[86:87] offset:128
    v_cvt_pk_bf16_f32 v88, v232, v233
    v_cvt_pk_bf16_f32 v89, v234, v235
    ds_write_b64 v74, v[88:89] offset:128
    v_cvt_pk_bf16_f32 v90, v236, v237
    v_cvt_pk_bf16_f32 v91, v238, v239
    ds_write_b64 v75, v[90:91] offset:128
    ds_write_b32 v15, v13
    s_add_u32 s45, s45, 32768
    s_cmp_ge_u32 s45, 147456
    s_cselect_b32 s60, 81920, 0
    s_sub_u32 s45, s45, s60
    s_add_u32 s53, s53, 8
    s_add_u32 s44, s44, 4
    s_cmp_lt_u32 s44, 18
    s_cbranch_scc1 L_round
    ds_read_b128 v[92:95], v2 offset:49152
    ds_read_b128 v[96:99], v2 offset:50176
    ds_read_b128 v[100:103], v2 offset:51200
    ds_read_b128 v[104:107], v2 offset:52224
    s_waitcnt lgkmcnt(3)
    buffer_store_dwordx4 v[92:95], v3, s[24:27], s39 offen offset:0 sc1 nt
    s_waitcnt lgkmcnt(2)
    buffer_store_dwordx4 v[96:99], v4, s[24:27], s39 offen offset:1024 sc1 nt
    s_waitcnt lgkmcnt(1)
    buffer_store_dwordx4 v[100:103], v3, s[24:27], s39 offen offset:2048 sc1 nt
    s_waitcnt lgkmcnt(0)
    buffer_store_dwordx4 v[104:107], v4, s[24:27], s39 offen offset:3072 sc1 nt
L_end:
    s_endpgm
.section .rodata,"a"
.p2align 6
.amdhsa_kernel standalone__sliding_local_fixed_window__prompt_kernel
  .amdhsa_next_free_vgpr 240
  .amdhsa_next_free_sgpr 62
  .amdhsa_accum_offset 240
  .amdhsa_group_segment_fixed_size 0
  .amdhsa_kernarg_size 48
  .amdhsa_user_sgpr_count 2
  .amdhsa_user_sgpr_kernarg_segment_ptr 1
  .amdhsa_system_sgpr_workgroup_id_x 1
  .amdhsa_float_denorm_mode_32 3
.end_amdhsa_kernel
```
